```python
import torch

def _softmax(x, axis=-1):
    return torch.softmax(x, dim=axis)
def _gelu(x):
    return torch.nn.functional.gelu(x, approximate="tanh")
def _silu(x):
    return torch.nn.functional.silu(x)
def _sigmoid(x):
    return torch.sigmoid(x)
def _layernorm(x, axis=-1, eps=1e-5):
    m = x.mean(dim=axis, keepdim=True)
    v = x.var(dim=axis, keepdim=True, unbiased=False)
    return (x - m) / torch.sqrt(v + eps)
def _scatter_add(tgt, idx, src, axis=0):
    return tgt.clone().index_add_(axis, idx, src)
def _segment_sum(src, seg, n):
    out = torch.zeros((n,) + src.shape[1:], dtype=src.dtype)
    return out.index_add_(0, seg, src)
def _pad(x, pw):
    flat = tuple(v for pair in reversed(pw) for v in pair)
    return torch.nn.functional.pad(x, flat)

kernel_name = 'parallel_sum__sliding_block_cached__glu_gated_reglu__decode'

def setup_inputs():

    _w = (lambda a: (lambda t: t.to(torch.bfloat16) if t.is_floating_point() else t)(torch.as_tensor(a)))
    def _A_setup():
        B, Sq, D = 2, 1, 512
        Hq, Hkv, Sk, Dh = 32, 8, 32768, 128
        assert Hq % Hkv == 0, (Hq, Hkv)
        return {
            "x": _w((lambda *s: torch.randn(*s, dtype=torch.bfloat16) * 0.05)(B, Sq, D)),
            "k_cache": _w((lambda *s: torch.randn(*s, dtype=torch.bfloat16) * 1.6)(B, Hkv, Sk, Dh)),
            "v_cache": _w((lambda *s: torch.randn(*s, dtype=torch.bfloat16) * 0.8)(B, Hkv, Sk, Dh)),
            "wq": _w((lambda *s: torch.randn(*s, dtype=torch.bfloat16) * 1.6)(D, Hq * Dh) * (D ** -0.5)),
            "wo": _w((lambda *s: torch.randn(*s, dtype=torch.bfloat16) * 0.8)(Hq * Dh, D) * ((Hq * Dh) ** -0.5)),
        }
    _A_in = _A_setup()

    def _B_setup():
        B, S, D, F = 2, 1, 512, 1792
        return {
            "x": _w((lambda *s: torch.randn(*s, dtype=torch.bfloat16) * 0.05)(B, S, D)),
            "W_gate": _w((lambda *s: torch.randn(*s, dtype=torch.bfloat16) * 0.4)(D, F) * (2.0 / D) ** 0.5),
            "W_up": _w((lambda *s: torch.randn(*s, dtype=torch.bfloat16) * 0.4)(D, F) * (2.0 / D) ** 0.5),
            "W_down": _w((lambda *s: torch.randn(*s, dtype=torch.bfloat16) * 0.4)(F, D) * (1.0 / F) ** 0.5),
        }
    _B_in = _B_setup()

    return {
        "A_x": _A_in["x"],
        "A_k_cache": _A_in["k_cache"],
        "A_v_cache": _A_in["v_cache"],
        "A_wq": _A_in["wq"],
        "A_wo": _A_in["wo"],
        "B_x": _B_in["x"],
        "B_W_gate": _B_in["W_gate"],
        "B_W_up": _B_in["W_up"],
        "B_W_down": _B_in["W_down"],
    }

def reference(A_x, A_k_cache, A_v_cache, A_wq, A_wo, B_x, B_W_gate, B_W_up, B_W_down):
    def _A_ref(x, k_cache, v_cache, wq, wo):
        B, Sq, D = x.shape
        Hq, Dh = 32, 128
        Hkv, Sk = k_cache.shape[1], k_cache.shape[2]
        W = min(4096, max(256, Sk // 4))
        rep = Hq // Hkv
        q = (lambda x, *d: x.permute(*d))((x @ wq).reshape(B, Sq, Hq, Dh), 0, 2, 1, 3)
        k = (lambda x, n, axis: torch.repeat_interleave(x, n, dim=axis))(k_cache[:, :, Sk - W:, :], rep, axis=1)
        v = (lambda x, n, axis: torch.repeat_interleave(x, n, dim=axis))(v_cache[:, :, Sk - W:, :], rep, axis=1)
        scores = torch.einsum("bhqd,bhkd->bhqk", q, k) * (Dh ** -0.5)
        p = _softmax(scores, axis=-1)
        o = torch.einsum("bhqk,bhkd->bhqd", p, v)
        return (lambda x, *d: x.permute(*d))(o, 0, 2, 1, 3).reshape(B, Sq, Hq * Dh) @ wo

    def _B_ref(x, W_gate, W_up, W_down):
        gate = torch.einsum("bsd,df->bsf", x, W_gate)
        up = torch.einsum("bsd,df->bsf", x, W_up)
        gate = gate * (lambda x, dt: x.to(dt))(gate > 0, gate.dtype)
        h = gate * up
        return torch.einsum("bsf,fd->bsd", h, W_down)

    x = A_x
    xn = _layernorm(x, axis=-1)
    return x + _A_ref(xn, A_k_cache, A_v_cache, A_wq, A_wo) + _B_ref(xn, B_W_gate, B_W_up, B_W_down)
```

```asm
; @launch grid=(256,1,1) block=(512,1,1) lds=163840
.amdgcn_target "amdgcn-amd-amdhsa--gfx950"
.text
.globl parallel_sum__sliding_block_cached__glu_gated_reglu__decode_kernel
.p2align 12
.p2align 8
.type parallel_sum__sliding_block_cached__glu_gated_reglu__decode_kernel,@function
parallel_sum__sliding_block_cached__glu_gated_reglu__decode_kernel:
    s_cmp_ge_u32 s2, 256
    s_cbranch_scc1 L_end
    s_load_dwordx16 s[8:23], s[0:1], 0
    s_load_dwordx8 s[24:31], s[0:1], 64
    v_lshrrev_b32 v3, 6, v0
    v_and_b32 v0, 63, v0
    v_readfirstlane_b32 s3, v3
    s_lshr_b32 s5, s2, 3
    s_and_b32 s33, s5, 3
    s_cmp_lg_u32 s3, 3
    s_cbranch_scc1 L_nopf
    s_getpc_b64 s[56:57]
    s_mul_i32 s58, s33, 2560
    v_min_u32 v3, 19, v0
    v_lshl_add_u32 v3, v3, 7, s58
    v_min_u32 v3, L_code_end-parallel_sum__sliding_block_cached__glu_gated_reglu__decode_kernel-128, v3
    global_load_dword v145, v3, s[56:57]
L_nopf:
    v_and_b32 v1, 15, v0
    v_lshrrev_b32 v2, 4, v0
    s_and_b32 s4, s2, 7
    s_lshr_b32 s6, s5, 4
    s_and_b32 s7, s5, 15
    s_lshr_b32 s32, s5, 2
    s_lshl_b32 s34, s4, 3
    s_add_u32 s34, s34, s32
    s_lshl_b32 s66, s4, 18
    s_add_u32 s66, s66, 262144
    v_lshrrev_b32 v6, 3, v0
    v_and_b32 v7, 1, v2
    v_lshlrev_b32 v7, 1, v7
    v_and_b32 v8, 7, v0
    v_xor_b32 v7, v7, v8
    v_lshlrev_b32 v7, 4, v7
    s_mov_b32 s46, s32
    s_add_u32 s47, s33, 1
    s_and_b32 s47, s47, 3
    s_and_b32 s56, s3, 3
    s_mov_b32 s43, 0x20000
    s_cmp_ge_u32 s3, 4
    s_cbranch_scc1 L_loader
    v_and_b32 v3, 1, v0
    v_lshlrev_b32 v3, 10, v3
    v_lshrrev_b32 v4, 1, v0
    v_lshl_add_u32 v4, v4, 5, v3
    v_lshrrev_b32 v5, 3, v1
    v_lshl_add_u32 v5, v5, 6, v3
    v_lshl_add_u32 v5, v2, 4, v5
    s_lshl_b32 s61, s46, 7
    v_add_u32 v5, s61, v5
    s_lshl_b32 s59, s7, 7
    s_lshl_b32 s62, s6, 15
    s_add_u32 s62, s62, 65536
    s_lshl_b32 s64, s6, 11
    s_add_u32 s64, s64, 163840
    s_cmp_eq_u32 s3, 0
    s_cselect_b32 s62, s62, s64
    s_cselect_b32 s64, 60, 0
    s_add_u32 s62, s62, s59
    v_and_b32 v20, s64, v0
    v_lshlrev_b32 v20, 9, v20
    v_and_b32 v21, 3, v0
    v_lshlrev_b32 v21, 4, v21
    v_add3_u32 v144, s62, v20, v21
    v_mov_b32 v24, -1
    v_mov_b32 v25, -1
    v_mov_b32 v26, -1
    v_mov_b32 v27, -1
    s_lshl_b32 s61, s3, 13
    s_add_u32 s61, s61, 139264
    s_cmp_lt_u32 s3, 2
    s_cbranch_scc0 L_s23
    s_waitcnt lgkmcnt(0)
    global_load_dwordx4 v[8:11], v4, s[8:9]
    global_load_dwordx4 v[12:15], v4, s[8:9] offset:16
    global_load_dwordx4 v[16:19], v5, s[8:9]
    s_add_u32 s28, s30, s66
    s_addc_u32 s29, s31, 0
    global_store_dwordx4 v144, v[24:27], s[28:29]
    s_load_dword s35, s[30:31], 0
    s_branch L_service
L_s23:
    s_mov_b32 s62, 0x48280803
    s_mov_b32 s63, 0xc0a98868
    s_lshl_b32 s57, s4, 3
    s_lshr_b64 s[62:63], s[62:63], s57
    s_lshr_b32 s63, s62, 2
    s_and_b32 s63, s63, 0x3e
    s_add_u32 s63, s63, s32
    s_and_b32 s62, s62, 7
    s_lshr_b32 s57, s32, 1
    s_add_u32 s57, s57, s62
    s_cmp_lt_u32 s57, 4
    s_cselect_b32 s54, 0x1c0000, 0
    v_mul_u32_u24 v30, 3584, v6
    v_add_u32 v31, v30, v7
    v_xor_b32 v7, 64, v7
    v_add_u32 v30, v30, v7
    s_sub_u32 s59, s63, s32
    s_lshr_b32 s59, s59, 1
    s_sub_u32 s67, s33, s3
    s_add_u32 s67, s67, 3
    s_sub_u32 s67, s67, s59
    s_and_b32 s67, s67, 3
    s_add_u32 s59, s59, s67
    s_add_u32 s58, s67, s62
    s_cmp_lt_u32 s58, 4
    s_cselect_b32 s54, 0x1c0000, 0
    s_mul_i32 s56, s46, 229376
    s_lshl_b32 s59, s59, 7
    s_add_u32 s56, s56, s59
    s_mov_b32 s42, s54
    s_sub_u32 s60, s61, 8192
    s_waitcnt lgkmcnt(0)
    s_add_u32 s28, s30, s66
    s_addc_u32 s29, s31, 0
    s_load_dword s35, s[30:31], 0
    s_cmp_eq_u32 s3, 2
    s_cselect_b32 s40, s20, s22
    s_cselect_b32 s41, s21, s23
    s_cbranch_scc1 L_wa
    s_call_b64 s[18:19], L_wm_s2
    s_branch L_wb
L_wa:
    s_call_b64 s[18:19], L_wm_s1
L_wb:
    global_load_dwordx4 v[8:11], v4, s[8:9]
    global_load_dwordx4 v[12:15], v4, s[8:9] offset:16
    global_load_dwordx4 v[16:19], v5, s[8:9]
    s_add_u32 s62, s60, 8192
L_tloop:
    s_mov_b32 m0, s60
    s_add_u32 s60, s60, 1024
    buffer_load_dwordx4 v31, s[40:43], s56 offen nt lds
    s_add_u32 s56, s56, 28672
    s_mov_b32 m0, s60
    s_add_u32 s60, s60, 1024
    buffer_load_dwordx4 v30, s[40:43], s56 offen nt lds
    s_add_u32 s56, s56, 28672
    s_cmp_lt_u32 s60, s62
    s_cbranch_scc1 L_tloop
    s_barrier
    s_cmp_eq_u32 s3, 2
    s_cbranch_scc1 L_we
    s_call_b64 s[18:19], L_wm_s5
    s_call_b64 s[18:19], L_wm_s7
    s_call_b64 s[18:19], L_wm_s9
    s_branch L_service
L_we:
    s_call_b64 s[18:19], L_wm_s4
    s_call_b64 s[18:19], L_wm_s6
    s_call_b64 s[18:19], L_wm_s8
    s_call_b64 s[18:19], L_wm_s10
    s_branch L_service
L_loader:
    s_lshl_b32 s36, s56, 2
    v_add_u32 v3, s36, v2
    v_xor_b32 v4, v3, v1
    v_lshlrev_b32 v4, 4, v4
    v_lshl_add_u32 v4, v2, 8, v4
    s_lshl_b32 s36, s6, 3
    s_add_u32 s36, s36, s4
    s_lshl_b32 s36, s36, 23
    s_lshl_b32 s59, s7, 16
    s_add_u32 s36, s36, s59
    s_add_u32 s36, s36, 0x700000
    s_mul_i32 s59, s2, 37
    s_add_u32 s59, s59, s56
    s_and_b32 s59, s59, 63
    s_lshl_b32 s59, s59, 10
    s_mov_b32 s42, 0x10000
    v_lshl_add_u32 v28, v6, 13, v7
    v_xor_b32 v29, 64, v28
    s_lshl_b32 s57, s46, 19
    s_lshl_b32 s58, s56, 17
    s_add_u32 s57, s57, s58
    s_lshl_b32 s58, s4, 2
    s_add_u32 s58, s58, s47
    s_lshl_b32 s58, s58, 8
    s_add_u32 s57, s57, s58
    s_add_u32 s58, s57, 0x10000
    s_lshl_b32 s60, s56, 11
    s_add_u32 s60, s60, 131072
    s_mov_b32 s50, 0x400000
    s_mov_b32 s51, 0x20000
    s_mov_b32 m0, s60
    s_waitcnt lgkmcnt(0)
    s_mov_b32 s48, s14
    s_mov_b32 s49, s15
    buffer_load_dwordx4 v28, s[48:51], s57 offen nt lds
    s_add_u32 m0, s60, 1024
    s_add_u32 s57, s57, 128
    buffer_load_dwordx4 v29, s[48:51], s58 offen nt lds
    s_add_u32 m0, s60, 8192
    s_add_u32 s58, s58, 128
    buffer_load_dwordx4 v28, s[48:51], s57 offen nt lds
    s_add_u32 m0, s60, 9216
    s_add_u32 s40, s10, s36
    s_addc_u32 s41, s11, 0
    buffer_load_dwordx4 v29, s[48:51], s58 offen nt lds
    s_lshl_b32 s60, s56, 10
L_kloop0:
    s_mov_b32 m0, s60
    s_add_u32 s60, s60, 4096
    buffer_load_dwordx4 v4, s[40:43], s59 offen nt lds
    s_add_u32 s59, s59, 4096
    s_and_b32 s59, s59, 0xffff
    s_cmp_lt_u32 s60, 16384
    s_cbranch_scc1 L_kloop0
    s_cmp_lg_u32 s56, 0
    s_cbranch_scc1 L_wc0
    s_call_b64 s[18:19], L_wm_t0
    s_branch L_wcd
L_wc0:
    s_cmp_lg_u32 s56, 1
    s_cbranch_scc1 L_wc1
    s_call_b64 s[18:19], L_wm_t1
    s_branch L_wcd
L_wc1:
    s_cmp_lg_u32 s56, 2
    s_cbranch_scc1 L_wc2
    s_call_b64 s[18:19], L_wm_t2
    s_branch L_wcd
L_wc2:
    s_call_b64 s[18:19], L_wm_t4
L_wcd:
    s_load_dword s35, s[30:31], 0
    s_add_u32 s28, s30, s66
    s_addc_u32 s29, s31, 0
    s_add_u32 s44, s12, s36
    s_addc_u32 s45, s13, 0
    s_mov_b32 s46, 0x10000
    s_mov_b32 s47, 0x20000
    s_mov_b32 s48, s16
    s_mov_b32 s49, s17
    s_mov_b32 s52, s24
    s_mov_b32 s53, s25
    s_mov_b32 s55, 0x20000
    s_mov_b32 s62, 0x48280803
    s_mov_b32 s63, 0xc0a98868
    s_lshl_b32 s57, s4, 3
    s_lshr_b64 s[62:63], s[62:63], s57
    s_lshr_b32 s63, s62, 2
    s_and_b32 s63, s63, 0x3e
    s_add_u32 s63, s63, s32
    s_and_b32 s62, s62, 7
    s_lshr_b32 s57, s32, 1
    s_add_u32 s57, s57, s62
    s_cmp_lt_u32 s57, 4
    s_cselect_b32 s54, 0x1c0000, 0
    v_and_b32 v5, 7, v3
    v_lshlrev_b32 v5, 1, v5
    v_xor_b32 v5, v5, v1
    v_lshlrev_b32 v5, 4, v5
    v_lshl_add_u32 v3, v3, 10, v5
    v_lshl_add_u32 v5, v2, 8, v5
    s_lshl_b32 s57, s33, 8
    s_lshl_b32 s61, s34, 16
    s_add_u32 s61, s61, s57
    s_lshl_b32 s63, s63, 15
    s_add_u32 s63, s63, s57
    v_and_b32 v13, 3, v1
    v_lshrrev_b32 v14, 2, v1
    v_and_b32 v15, 1, v2
    v_and_b32 v7, 1, v1
    s_and_b32 s36, s56, 1
    v_lshlrev_b32 v108, 10, v14
    v_and_b32 v8, 2, v1
    v_lshl_add_u32 v108, v8, 8, v108
    v_lshl_add_u32 v108, v7, 6, v108
    v_lshl_add_u32 v108, v2, 4, v108
    s_lshr_b32 s37, s32, 1
    s_lshl_b32 s57, s37, 13
    s_and_b32 s58, s32, 1
    s_lshl_b32 s58, s58, 7
    s_add_u32 s57, s57, s58
    s_lshl_b32 s58, s36, 8
    s_add_u32 s57, s57, s58
    s_add_u32 s57, s57, 34816
    v_add_u32 v108, s57, v108
    s_lshl_b32 s58, s36, 15
    s_lshl_b32 s57, s32, 12
    s_add_u32 s58, s58, s57
    s_add_u32 s58, s58, 65536
    v_lshlrev_b32 v123, 7, v1
    v_lshl_add_u32 v109, v2, 4, v123
    v_add_u32 v109, s58, v109
    s_lshl_b32 s58, s36, 11
    s_add_u32 s57, s58, 167936
    v_add_u32 v123, s57, v123
    s_lshl_b32 s57, s37, 2
    s_add_u32 s58, s58, s57
    s_add_u32 s58, s58, 163840
    v_lshl_add_u32 v110, v2, 2, v13
    v_lshlrev_b32 v110, 7, v110
    v_add_u32 v110, s58, v110
    s_lshl_b32 s58, s5, 7
    s_add_u32 s58, s58, 167936
    v_mov_b32 v118, s58
    v_lshl_add_u32 v8, v15, 2, v14
    s_lshl_b32 s58, s56, 1
    s_and_b32 s58, s58, 4
    v_xor_b32 v8, s58, v8
    v_lshlrev_b32 v8, 5, v8
    v_lshl_add_u32 v111, v14, 8, v8
    v_lshl_add_u32 v111, v13, 3, v111
    v_lshl_add_u32 v111, v2, 13, v111
    v_add_u32 v111, 131072, v111
    v_xor_b32 v112, 32, v111
    v_xor_b32 v113, 64, v111
    v_xor_b32 v114, 0x60, v111
    v_lshrrev_b32 v115, 1, v2
    v_lshl_add_u32 v115, v15, 1, v115
    v_lshl_add_u32 v115, v115, 4, v1
    v_lshlrev_b32 v115, 2, v115
    s_lshl_b32 s58, s36, 20
    s_lshl_b32 s57, s33, 18
    s_add_u32 s58, s58, s57
    s_lshr_b32 s57, s56, 1
    s_lshl_b32 s57, s57, 14
    s_add_u32 s58, s58, s57
    s_lshl_b32 s57, s34, 8
    s_add_u32 s58, s58, s57
    s_add_u32 s58, s58, 393216
    v_add_u32 v115, s58, v115
    v_lshlrev_b32 v117, 3, v13
    v_mov_b32 v121, 0xff
    v_mov_b32 v10, 137728
    s_mov_b32 s36, 0x0c0c0400
    s_mov_b32 s37, 0x04000c0c
    s_mov_b32 s38, 0xf8ffffff
    s_mov_b32 s62, 0xffff0000
    s_waitcnt vmcnt(4)
    s_barrier
L_kloop:
    s_waitcnt vmcnt(6)
    s_mov_b32 m0, s60
    s_add_u32 s60, s60, 4096
    buffer_load_dwordx4 v4, s[40:43], s59 offen nt lds
    s_add_u32 s59, s59, 4096
    s_and_b32 s59, s59, 0xffff
    s_cmp_lt_u32 s60, 65536
    s_cbranch_scc1 L_kloop
L_vloop:
    s_waitcnt vmcnt(7)
    s_mov_b32 m0, s60
    s_add_u32 s60, s60, 4096
    buffer_load_dwordx4 v5, s[44:47], s59 offen nt lds
    s_add_u32 s59, s59, 4096
    s_and_b32 s59, s59, 0xffff
    s_cmp_lt_u32 s60, 106496
    s_cbranch_scc1 L_vloop
    s_waitcnt vmcnt(10) lgkmcnt(0)
    s_add_u32 s35, s35, 134283521
    s_lshl_b32 s57, s56, 13
    s_add_u32 s57, s57, 131072
    v_lshrrev_b32 v117, v117, s35
    v_mov_b32 v33, s35
    s_barrier
    ds_read_b32 v8, v10
    ds_read_b32 v9, v10 offset:8192
    s_add_u32 m0, s57, 4096
    s_waitcnt vmcnt(7)
    buffer_load_dwordx4 v3, s[52:55], s63 offen nt lds
    s_add_u32 s63, s63, 16384
    s_add_u32 m0, s57, 5120
    s_waitcnt vmcnt(7)
    buffer_load_dwordx4 v3, s[52:55], s63 offen nt lds
    s_add_u32 s63, s63, 16384
L_vloop1:
    s_waitcnt vmcnt(7)
    s_mov_b32 m0, s60
    s_add_u32 s60, s60, 4096
    buffer_load_dwordx4 v5, s[44:47], s59 offen nt lds
    s_add_u32 s59, s59, 4096
    s_and_b32 s59, s59, 0xffff
    s_cmp_lt_u32 s60, 110592
    s_cbranch_scc1 L_vloop1
    global_load_dwordx4 v[124:127], v108, s[28:29] offset:-2048 sc1 nt
    global_load_dwordx4 v[28:31], v108, s[28:29] offset:2048 sc1 nt
L_vloop2:
    s_waitcnt vmcnt(7)
    s_mov_b32 m0, s60
    s_add_u32 s60, s60, 4096
    buffer_load_dwordx4 v5, s[44:47], s59 offen nt lds
    s_add_u32 s59, s59, 4096
    s_and_b32 s59, s59, 0xffff
    s_cmp_lt_u32 s60, 122880
    s_cbranch_scc1 L_vloop2
    s_waitcnt vmcnt(10) lgkmcnt(0)
    v_or_b32 v8, v8, v9
    s_barrier
    v_readfirstlane_b32 s69, v8
L_vloop3:
    s_waitcnt vmcnt(7)
    s_mov_b32 m0, s60
    s_add_u32 s60, s60, 4096
    buffer_load_dwordx4 v5, s[44:47], s59 offen nt lds
    s_add_u32 s59, s59, 4096
    s_and_b32 s59, s59, 0xffff
    s_cmp_lt_u32 s60, 131072
    s_cbranch_scc1 L_vloop3
    global_load_dword v24, v110, s[28:29] sc1
    s_add_u32 m0, s57, 0
    s_waitcnt vmcnt(7)
    buffer_load_dwordx4 v3, s[48:51], s61 offen nt lds
    s_add_u32 s61, s61, 16384
    s_add_u32 m0, s57, 1024
    s_waitcnt vmcnt(7)
    buffer_load_dwordx4 v3, s[48:51], s61 offen nt lds
    s_add_u32 s61, s61, 16384
    s_add_u32 m0, s57, 2048
    s_waitcnt vmcnt(7)
    buffer_load_dwordx4 v3, s[48:51], s61 offen nt lds
    s_add_u32 s61, s61, 16384
    s_add_u32 m0, s57, 3072
    s_waitcnt vmcnt(7)
    buffer_load_dwordx4 v3, s[48:51], s61 offen nt lds
    s_add_u32 s61, s61, 16384
    s_branch L_ltail
L_service:
    s_mov_b32 s62, 0xffff0000
    s_mov_b32 s64, 0x000f000f
    s_mov_b32 s65, 0x000f000f
    v_and_b32 v4, 3, v1
    v_lshrrev_b32 v5, 2, v1
    v_and_b32 v6, 1, v2
    v_lshrrev_b32 v96, 3, v1
    v_lshl_add_u32 v96, v6, 1, v96
    v_lshlrev_b32 v96, 5, v96
    v_lshl_add_u32 v96, v5, 7, v96
    v_lshl_add_u32 v96, v2, 10, v96
    v_lshl_add_u32 v96, v4, 3, v96
    s_sub_u32 s60, s61, 8192
    v_add_u32 v96, s60, v96
    v_xor_b32 v97, 32, v96
    v_xor_b32 v92, 64, v96
    v_xor_b32 v93, 0x60, v96
    s_cmp_lt_u32 s3, 2
    s_cselect_b32 s57, 14, 8
    v_and_b32 v3, 1, v1
    v_lshlrev_b32 v98, s57, v3
    v_lshrrev_b32 v7, 1, v1
    v_lshl_add_u32 v98, v7, 6, v98
    v_lshl_add_u32 v98, v2, 4, v98
    s_lshl_b32 s57, s47, 9
    s_lshl_b32 s58, s3, 8
    s_add_u32 s57, s57, s58
    s_lshl_b32 s58, s46, 11
    s_add_u32 s57, s57, s58
    s_lshl_b32 s63, s67, 13
    s_lshl_b32 s58, s46, 10
    s_add_u32 s58, s58, s63
    s_lshl_b32 s56, s3, 9
    s_add_u32 s58, s58, s56
    s_add_u32 s58, s58, 31744
    s_cmp_lt_u32 s3, 2
    s_cselect_b32 s57, s57, s58
    v_add_u32 v98, s57, v98
    v_cmp_eq_u32 s[44:45], 1, v7
    v_cmp_eq_u32 s[46:47], 2, v7
    v_cmp_eq_u32 s[48:49], 3, v7
    s_lshl_b32 s57, s6, 14
    s_lshl_b32 s58, s3, 10
    s_add_u32 s57, s57, s58
    s_add_u32 s57, s57, 4096
    v_lshlrev_b32 v99, 4, v0
    v_add_u32 v99, s57, v99
    v_add_u32 v94, 0x2000, v99
    s_add_u32 s60, s60, 6144
    v_lshlrev_b32 v100, 3, v0
    v_add_u32 v100, s60, v100
    v_mov_b32 v121, 0xff
    v_xor_b32 v101, v2, v1
    v_lshlrev_b32 v101, 4, v101
    v_lshl_add_u32 v101, v1, 8, v101
    s_lshl_b32 s59, s3, 14
    v_add_u32 v101, s59, v101
    v_xor_b32 v102, 64, v101
    v_xor_b32 v103, 0x80, v101
    v_xor_b32 v104, 0xc0, v101
    v_and_b32 v105, 2, v1
    v_lshlrev_b32 v105, 12, v105
    v_lshl_add_u32 v105, v3, 8, v105
    v_lshl_add_u32 v105, v2, 4, v105
    v_add_u32 v105, 137216, v105
    s_lshl_b32 s57, s6, 14
    s_lshl_b32 s58, s7, 4
    s_add_u32 s57, s57, s58
    s_add_u32 s57, s57, 131072
    v_lshlrev_b32 v116, 8, v0
    v_add_u32 v116, s57, v116
    v_lshrrev_b32 v120, 1, v2
    v_lshl_add_u32 v120, v6, 1, v120
    s_lshl_b32 s57, s4, 5
    s_add_u32 s57, s57, s5
    s_lshl_b32 s57, s57, 3
    v_lshl_add_u32 v120, v120, 1, s57
    s_getreg_b32 s68, hwreg(HW_REG_XCC_ID)
    s_and_b32 s68, s68, 7
    s_cmp_lt_u32 s3, 2
    s_cbranch_scc1 L_ln0
    s_waitcnt vmcnt(8)
    s_branch L_ln
L_wm_s1:
    s_setpc_b64 s[18:19]
    s_nop 0
L_ln0:
    s_waitcnt vmcnt(1)
L_ln:
    v_lshlrev_b32 v32, 16, v8
    v_and_b32 v33, s62, v8
    v_lshlrev_b32 v34, 16, v9
    v_and_b32 v35, s62, v9
    v_lshlrev_b32 v36, 16, v10
    v_and_b32 v37, s62, v10
    v_lshlrev_b32 v38, 16, v11
    v_and_b32 v39, s62, v11
    v_lshlrev_b32 v40, 16, v12
    v_and_b32 v41, s62, v12
    v_lshlrev_b32 v42, 16, v13
    v_and_b32 v43, s62, v13
    v_lshlrev_b32 v44, 16, v14
    v_and_b32 v45, s62, v14
    v_lshlrev_b32 v46, 16, v15
    v_and_b32 v47, s62, v15
    v_pk_add_f32 v[48:49], v[32:33], v[34:35]
    v_pk_add_f32 v[50:51], v[36:37], v[38:39]
    v_pk_add_f32 v[52:53], v[40:41], v[42:43]
    v_pk_add_f32 v[54:55], v[44:45], v[46:47]
    v_pk_add_f32 v[48:49], v[48:49], v[50:51]
    v_pk_add_f32 v[52:53], v[52:53], v[54:55]
    v_pk_add_f32 v[48:49], v[48:49], v[52:53]
    v_add_f32 v48, v48, v49
    s_nop 1
    v_add_f32_dpp v48, v48, v48 quad_perm:[2,3,0,1] row_mask:0xf bank_mask:0xf
    s_nop 1
    v_add_f32_dpp v48, v48, v48 row_ror:4 row_mask:0xf bank_mask:0xf
    s_nop 1
    v_add_f32_dpp v48, v48, v48 row_ror:8 row_mask:0xf bank_mask:0xf
    v_mov_b32 v49, v48
    s_nop 1
    v_permlane16_swap_b32 v48, v49
    v_add_f32 v48, v48, v49
    v_mov_b32 v49, v48
    s_nop 1
    v_permlane32_swap_b32 v48, v49
    v_add_f32 v48, v48, v49
    v_mul_f32 v48, 0xbb000000, v48
    v_mov_b32 v49, v48
    v_pk_add_f32 v[32:33], v[32:33], v[48:49]
    v_pk_add_f32 v[34:35], v[34:35], v[48:49]
    v_pk_add_f32 v[36:37], v[36:37], v[48:49]
    v_pk_add_f32 v[38:39], v[38:39], v[48:49]
    v_pk_add_f32 v[40:41], v[40:41], v[48:49]
    v_pk_add_f32 v[42:43], v[42:43], v[48:49]
    v_pk_add_f32 v[44:45], v[44:45], v[48:49]
    v_pk_add_f32 v[46:47], v[46:47], v[48:49]
    v_pk_mul_f32 v[50:51], v[32:33], v[32:33]
    v_pk_mul_f32 v[52:53], v[34:35], v[34:35]
    v_pk_fma_f32 v[50:51], v[36:37], v[36:37], v[50:51]
    v_pk_fma_f32 v[52:53], v[38:39], v[38:39], v[52:53]
    v_pk_fma_f32 v[50:51], v[40:41], v[40:41], v[50:51]
    v_pk_fma_f32 v[52:53], v[42:43], v[42:43], v[52:53]
    v_pk_fma_f32 v[50:51], v[44:45], v[44:45], v[50:51]
    v_pk_fma_f32 v[52:53], v[46:47], v[46:47], v[52:53]
    v_pk_add_f32 v[50:51], v[50:51], v[52:53]
    v_add_f32 v50, v50, v51
    v_cvt_pk_bf16_f32 v48, v48, v48
    v_and_b32 v48, s62, v48
    v_mov_b32 v49, v48
    v_add_f32_dpp v50, v50, v50 quad_perm:[2,3,0,1] row_mask:0xf bank_mask:0xf
    v_lshlrev_b32 v32, 16, v16
    v_and_b32 v33, s62, v16
    v_add_f32_dpp v50, v50, v50 row_ror:4 row_mask:0xf bank_mask:0xf
    v_lshlrev_b32 v34, 16, v17
    v_and_b32 v35, s62, v17
    v_add_f32_dpp v50, v50, v50 row_ror:8 row_mask:0xf bank_mask:0xf
    v_mov_b32 v51, v50
    v_lshlrev_b32 v36, 16, v18
    v_and_b32 v37, s62, v18
    v_permlane16_swap_b32 v50, v51
    v_add_f32 v50, v50, v51
    v_mov_b32 v51, v50
    v_lshlrev_b32 v38, 16, v19
    v_and_b32 v39, s62, v19
    v_permlane32_swap_b32 v50, v51
    v_add_f32 v50, v50, v51
    v_mul_f32 v50, 0x3b000000, v50
    v_cvt_pk_bf16_f32 v50, v50, v50
    v_and_b32 v50, s62, v50
    v_add_f32 v50, 0x3727c5ac, v50
    v_cvt_pk_bf16_f32 v50, v50, v50
    v_and_b32 v50, s62, v50
    v_sqrt_f32 v50, v50
    v_pk_add_f32 v[32:33], v[32:33], v[48:49]
    v_cvt_pk_bf16_f32 v50, v50, v50
    v_and_b32 v50, s62, v50
    v_rcp_f32 v50, v50
    v_pk_add_f32 v[34:35], v[34:35], v[48:49]
    v_mov_b32 v51, v50
    s_branch L_wo_s2
.p2align 12, , 400
L_wm_s2:
    s_setpc_b64 s[18:19]
L_wo_s2:
    v_pk_add_f32 v[36:37], v[36:37], v[48:49]
    v_pk_add_f32 v[38:39], v[38:39], v[48:49]
    v_cvt_pk_bf16_f32 v16, v32, v33
    v_cvt_pk_bf16_f32 v17, v34, v35
    v_cvt_pk_bf16_f32 v18, v36, v37
    v_cvt_pk_bf16_f32 v19, v38, v39
    v_lshlrev_b32 v32, 16, v16
    v_and_b32 v33, s62, v16
    v_lshlrev_b32 v34, 16, v17
    v_and_b32 v35, s62, v17
    v_lshlrev_b32 v36, 16, v18
    v_and_b32 v37, s62, v18
    v_lshlrev_b32 v38, 16, v19
    v_and_b32 v39, s62, v19
    v_pk_mul_f32 v[32:33], v[32:33], v[50:51]
    v_pk_mul_f32 v[34:35], v[34:35], v[50:51]
    v_pk_mul_f32 v[36:37], v[36:37], v[50:51]
    v_pk_mul_f32 v[38:39], v[38:39], v[50:51]
    v_cvt_pk_bf16_f32 v16, v32, v33
    v_cvt_pk_bf16_f32 v17, v34, v35
    v_cvt_pk_bf16_f32 v18, v36, v37
    v_cvt_pk_bf16_f32 v19, v38, v39
    v_mov_b32_dpp v20, v16 row_ror:8 row_mask:0xf bank_mask:0xf
    v_mov_b32_dpp v21, v17 row_ror:8 row_mask:0xf bank_mask:0xf
    v_mov_b32_dpp v22, v18 row_ror:8 row_mask:0xf bank_mask:0xf
    v_mov_b32_dpp v23, v19 row_ror:8 row_mask:0xf bank_mask:0xf
    s_waitcnt lgkmcnt(0)
    s_add_u32 s35, s35, 134283521
    s_lshr_b32 s36, s35, 8
    s_lshr_b32 s37, s35, 16
    s_lshr_b32 s38, s35, 24
    s_and_b32 s38, s38, 0xf8
    s_or_b32 s38, s38, s68
    s_and_b32 s39, s35, 0x00ffffff
    s_lshl_b32 s57, s38, 24
    s_or_b32 s39, s39, s57
    s_mov_b32 s56, 0x00ff00ff
    s_mov_b32 s57, 0x00ff00ff
    s_cmp_lt_u32 s3, 2
    s_waitcnt vmcnt(0)
    s_cbranch_scc0 L_w3
    s_barrier
L_w3:
    ds_read_b64_tr_b16 v[48:49], v96 offset:0
    ds_read_b64_tr_b16 v[50:51], v96 offset:512
    ds_read_b64_tr_b16 v[52:53], v96 offset:4096
    ds_read_b64_tr_b16 v[54:55], v96 offset:4608
    ds_read_b64_tr_b16 v[56:57], v97 offset:0
    ds_read_b64_tr_b16 v[58:59], v97 offset:512
    ds_read_b64_tr_b16 v[60:61], v97 offset:4096
    ds_read_b64_tr_b16 v[62:63], v97 offset:4608
    ds_read_b64_tr_b16 v[64:65], v92 offset:0
    ds_read_b64_tr_b16 v[66:67], v92 offset:512
    ds_read_b64_tr_b16 v[68:69], v92 offset:4096
    ds_read_b64_tr_b16 v[70:71], v92 offset:4608
    ds_read_b64_tr_b16 v[72:73], v93 offset:0
    ds_read_b64_tr_b16 v[74:75], v93 offset:512
    ds_read_b64_tr_b16 v[76:77], v93 offset:4096
    ds_read_b64_tr_b16 v[78:79], v93 offset:4608
    s_waitcnt lgkmcnt(12)
    v_mfma_f32_16x16x32_bf16 v[32:35], v[48:51], v[16:19], 0
    v_mfma_f32_16x16x32_bf16 v[32:35], v[52:55], v[20:23], v[32:35]
    s_waitcnt lgkmcnt(8)
    v_mfma_f32_16x16x32_bf16 v[36:39], v[56:59], v[16:19], 0
    v_mfma_f32_16x16x32_bf16 v[36:39], v[60:63], v[20:23], v[36:39]
    s_waitcnt lgkmcnt(4)
    v_mfma_f32_16x16x32_bf16 v[40:43], v[64:67], v[16:19], 0
    v_mfma_f32_16x16x32_bf16 v[40:43], v[68:71], v[20:23], v[40:43]
    s_waitcnt lgkmcnt(0)
    v_mfma_f32_16x16x32_bf16 v[44:47], v[72:75], v[16:19], 0
    v_mfma_f32_16x16x32_bf16 v[44:47], v[76:79], v[20:23], v[44:47]
    s_nop 1
    v_cndmask_b32 v32, v32, v36, s[44:45]
    v_cndmask_b32 v33, v33, v37, s[44:45]
    v_cndmask_b32 v34, v34, v38, s[44:45]
    v_cndmask_b32 v35, v35, v39, s[44:45]
    v_cndmask_b32 v32, v32, v40, s[46:47]
    v_cndmask_b32 v33, v33, v41, s[46:47]
    v_cndmask_b32 v34, v34, v42, s[46:47]
    v_cndmask_b32 v35, v35, v43, s[46:47]
    v_cndmask_b32 v32, v32, v44, s[48:49]
    v_cndmask_b32 v33, v33, v45, s[48:49]
    v_cndmask_b32 v34, v34, v46, s[48:49]
    v_cndmask_b32 v35, v35, v47, s[48:49]
    v_bfi_b32 v32, v121, s35, v32
    v_bfi_b32 v33, v121, s36, v33
    v_bfi_b32 v34, v121, s37, v34
    v_bfi_b32 v35, v121, s38, v35
    s_mov_b64 exec, s[56:57]
    global_store_dwordx4 v98, v[32:35], s[28:29]
L_xpubd:
    s_mov_b64 exec, -1
    s_branch L_wo_s4
.p2align 12, , 400
L_wm_s4:
    s_setpc_b64 s[18:19]
L_wo_s4:
    v_lshlrev_b32 v250, 4, v4
    v_lshl_add_u32 v250, v2, 6, v250
    v_add_u32 v250, 161792, v250
    v_lshrrev_b32 v106, 1, v5
    v_lshl_add_u32 v106, v106, 8, v250
    v_and_b32 v8, 1, v5
    v_lshl_add_u32 v106, v8, 3, v106
    s_lshl_b32 s59, s3, 9
    v_add_u32 v106, s59, v106
    v_lshlrev_b32 v122, 5, v4
    v_add_u32 v122, 153600, v122
    s_lshl_b32 s59, s3, 2
    v_add_u32 v107, s59, v122
    v_lshl_add_u32 v248, v2, 2, v5
    v_and_b32 v249, 7, v248
    s_lshl_b32 s58, s3, 1
    v_xor_b32 v249, s58, v249
    v_lshlrev_b32 v249, 5, v249
    v_lshl_add_u32 v248, v248, 8, v249
    v_lshl_add_u32 v248, v4, 3, v248
    v_add_u32 v248, 0x10000, v248
    v_xor_b32 v249, 32, v248
    s_lshl_b32 s58, s6, 15
    s_lshl_b32 s59, s3, 11
    s_add_u32 s58, s58, s59
    s_lshl_b32 s59, s7, 7
    s_add_u32 s58, s58, s59
    s_add_u32 s58, s58, 65536
    v_lshlrev_b32 v251, 13, v4
    v_lshl_add_u32 v251, v2, 4, v251
    v_add_u32 v251, s58, v251
    s_lshl_b32 s58, s5, 7
    s_add_u32 s58, s58, 163840
    v_lshl_add_u32 v118, v0, 2, s58
    v_cmp_eq_u32 s[44:45], 1, v5
    v_cmp_eq_u32 s[46:47], 2, v5
    v_cmp_eq_u32 s[48:49], 3, v5
    v_mov_b32 v10, 137728
    s_mov_b32 s58, 0x0c0c0400
    s_mov_b32 s59, 0x04000c0c
    s_mov_b32 s61, 0xf8ffffff
    s_cmp_ge_u32 s3, 2
    s_cbranch_scc1 L_qskip
    global_load_dword v144, v144, s[28:29] sc1 nt
    global_load_ushort v119, v120, s[8:9]
L_nqw:
    s_mov_b32 s57, 0
L_qpoll:
    global_load_dwordx4 v[32:35], v99, s[28:29] offset:-4096 sc1 nt
    global_load_dwordx4 v[36:39], v99, s[28:29] offset:-2048 sc1 nt
    global_load_dwordx4 v[40:43], v99, s[28:29] offset:0 sc1 nt
    global_load_dwordx4 v[44:47], v99, s[28:29] offset:2048 sc1 nt
    global_load_dwordx4 v[48:51], v94, s[28:29] offset:-4096 sc1 nt
    global_load_dwordx4 v[52:55], v94, s[28:29] offset:-2048 sc1 nt
    global_load_dwordx4 v[56:59], v94, s[28:29] offset:0 sc1 nt
    global_load_dwordx4 v[60:63], v94, s[28:29] offset:2048 sc1 nt
    s_branch L_wo_s5
.p2align 12, , 640
L_wm_s5:
    s_setpc_b64 s[18:19]
L_wo_s5:
    s_waitcnt vmcnt(7)
    v_perm_b32 v64, v33, v32, s58
    v_perm_b32 v65, v35, v34, s59
    v_bitop3_b32 v64, v64, v65, s39 bitop3:0x56
    s_waitcnt vmcnt(6)
    v_perm_b32 v66, v37, v36, s58
    v_perm_b32 v67, v39, v38, s59
    v_bitop3_b32 v66, v66, v67, s39 bitop3:0x56
    s_waitcnt vmcnt(5)
    v_perm_b32 v68, v41, v40, s58
    v_perm_b32 v69, v43, v42, s59
    v_bitop3_b32 v68, v68, v69, s39 bitop3:0x56
    s_waitcnt vmcnt(4)
    v_perm_b32 v70, v45, v44, s58
    v_perm_b32 v71, v47, v46, s59
    v_bitop3_b32 v70, v70, v71, s39 bitop3:0x56
    s_waitcnt vmcnt(3)
    v_perm_b32 v72, v49, v48, s58
    v_perm_b32 v73, v51, v50, s59
    v_bitop3_b32 v72, v72, v73, s39 bitop3:0x56
    s_waitcnt vmcnt(2)
    v_perm_b32 v74, v53, v52, s58
    v_perm_b32 v75, v55, v54, s59
    v_bitop3_b32 v74, v74, v75, s39 bitop3:0x56
    s_waitcnt vmcnt(1)
    v_perm_b32 v76, v57, v56, s58
    v_perm_b32 v77, v59, v58, s59
    v_bitop3_b32 v76, v76, v77, s39 bitop3:0x56
    s_waitcnt vmcnt(0)
    v_perm_b32 v78, v61, v60, s58
    v_perm_b32 v79, v63, v62, s59
    v_bitop3_b32 v78, v78, v79, s39 bitop3:0x56
    v_or3_b32 v64, v64, v66, v68
    v_or3_b32 v70, v70, v72, v74
    v_or3_b32 v64, v64, v76, v78
    v_or_b32 v80, v64, v70
    v_and_b32 v64, s61, v80
    v_cmp_ne_u32 vcc, 0, v64
    s_add_u32 s57, s57, 1
    s_mov_b64 exec, vcc
    s_cbranch_execz L_qdone
    s_cmp_lt_u32 s57, 12
    s_cbranch_scc1 L_qpoll
    buffer_wbl2 sc1
    buffer_inv sc1
    s_waitcnt vmcnt(0)
    s_cmp_lt_u32 s57, 40000
    s_cbranch_scc1 L_qpoll
L_qdone:
    s_mov_b64 exec, -1
    v_cmp_ne_u32 vcc, 0, v80
    s_movk_i32 s56, 0xff00
    v_and_b32 v32, s56, v32
    v_and_b32 v33, s56, v33
    v_and_b32 v34, s56, v34
    v_and_b32 v35, s56, v35
    v_and_b32 v36, s56, v36
    v_and_b32 v37, s56, v37
    v_and_b32 v38, s56, v38
    v_and_b32 v39, s56, v39
    v_and_b32 v40, s56, v40
    v_and_b32 v41, s56, v41
    v_and_b32 v42, s56, v42
    v_and_b32 v43, s56, v43
    v_and_b32 v44, s56, v44
    v_and_b32 v45, s56, v45
    v_and_b32 v46, s56, v46
    v_and_b32 v47, s56, v47
    v_and_b32 v48, s56, v48
    v_and_b32 v49, s56, v49
    v_and_b32 v50, s56, v50
    v_and_b32 v51, s56, v51
    v_and_b32 v52, s56, v52
    v_and_b32 v53, s56, v53
    v_and_b32 v54, s56, v54
    v_and_b32 v55, s56, v55
    v_and_b32 v56, s56, v56
    v_and_b32 v57, s56, v57
    v_and_b32 v58, s56, v58
    v_and_b32 v59, s56, v59
    v_and_b32 v60, s56, v60
    v_and_b32 v61, s56, v61
    v_and_b32 v62, s56, v62
    v_and_b32 v63, s56, v63
    s_or_b32 s56, vcc_lo, vcc_hi
    v_pk_add_f32 v[32:33], v[32:33], v[36:37]
    v_pk_add_f32 v[34:35], v[34:35], v[38:39]
    v_pk_add_f32 v[40:41], v[40:41], v[44:45]
    v_pk_add_f32 v[42:43], v[42:43], v[46:47]
    v_pk_add_f32 v[48:49], v[48:49], v[52:53]
    v_pk_add_f32 v[50:51], v[50:51], v[54:55]
    v_pk_add_f32 v[56:57], v[56:57], v[60:61]
    v_pk_add_f32 v[58:59], v[58:59], v[62:63]
    v_pk_add_f32 v[32:33], v[32:33], v[40:41]
    v_pk_add_f32 v[34:35], v[34:35], v[42:43]
    v_pk_add_f32 v[48:49], v[48:49], v[56:57]
    v_pk_add_f32 v[50:51], v[50:51], v[58:59]
    v_pk_add_f32 v[32:33], v[32:33], v[48:49]
    v_pk_add_f32 v[34:35], v[34:35], v[50:51]
    v_cvt_pk_bf16_f32 v32, v32, v33
    v_cvt_pk_bf16_f32 v33, v34, v35
    v_mov_b32 v34, s56
    v_mov_b32 v35, s60
    ds_write_b64 v100, v[32:33]
    ds_write_b32 v35, v34 offset:512
L_qskip:
L_nmwb:
    s_mov_b32 s56, 1035273459
    s_mov_b32 s57, 1069066811
    s_branch L_wo_s6
.p2align 12, , 400
L_wm_s6:
    s_setpc_b64 s[18:19]
L_wo_s6:
    s_waitcnt lgkmcnt(0)
    s_barrier
    ds_read_b128 v[16:19], v105 offset:0
    ds_read_b128 v[20:23], v105 offset:64
    ds_read_b128 v[24:27], v105 offset:128
    ds_read_b128 v[28:31], v105 offset:192
    ds_read_b128 v[32:35], v101 offset:0
    ds_read_b128 v[36:39], v102 offset:0
    ds_read_b128 v[40:43], v103 offset:0
    ds_read_b128 v[44:47], v104 offset:0
    ds_read_b128 v[48:51], v101 offset:4096
    ds_read_b128 v[52:55], v102 offset:4096
    ds_read_b128 v[56:59], v103 offset:4096
    ds_read_b128 v[60:63], v104 offset:4096
    s_waitcnt lgkmcnt(4)
    v_mfma_f32_16x16x32_bf16 v[128:131], v[32:35], v[16:19], 0
    v_mfma_f32_16x16x32_bf16 v[128:131], v[36:39], v[20:23], v[128:131]
    v_mfma_f32_16x16x32_bf16 v[128:131], v[40:43], v[24:27], v[128:131]
    v_mfma_f32_16x16x32_bf16 v[128:131], v[44:47], v[28:31], v[128:131]
    ds_read_b128 v[64:67], v101 offset:8192
    ds_read_b128 v[68:71], v102 offset:8192
    ds_read_b128 v[72:75], v103 offset:8192
    ds_read_b128 v[76:79], v104 offset:8192
    s_waitcnt lgkmcnt(4)
    v_mfma_f32_16x16x32_bf16 v[132:135], v[48:51], v[16:19], 0
    v_mfma_f32_16x16x32_bf16 v[132:135], v[52:55], v[20:23], v[132:135]
    v_mfma_f32_16x16x32_bf16 v[132:135], v[56:59], v[24:27], v[132:135]
    v_mfma_f32_16x16x32_bf16 v[132:135], v[60:63], v[28:31], v[132:135]
    ds_read_b128 v[80:83], v101 offset:12288
    ds_read_b128 v[84:87], v102 offset:12288
    ds_read_b128 v[88:91], v103 offset:12288
    ds_read_b128 v[92:95], v104 offset:12288
    ds_read_b32 v8, v10
    ds_read_b32 v9, v10 offset:8192
    s_waitcnt lgkmcnt(6)
    v_mfma_f32_16x16x32_bf16 v[136:139], v[64:67], v[16:19], 0
    v_mfma_f32_16x16x32_bf16 v[136:139], v[68:71], v[20:23], v[136:139]
    v_mfma_f32_16x16x32_bf16 v[136:139], v[72:75], v[24:27], v[136:139]
    v_mfma_f32_16x16x32_bf16 v[136:139], v[76:79], v[28:31], v[136:139]
    s_waitcnt lgkmcnt(2)
    v_mfma_f32_16x16x32_bf16 v[140:143], v[80:83], v[16:19], 0
    v_mfma_f32_16x16x32_bf16 v[140:143], v[84:87], v[20:23], v[140:143]
    v_mfma_f32_16x16x32_bf16 v[140:143], v[88:91], v[24:27], v[140:143]
    v_mfma_f32_16x16x32_bf16 v[140:143], v[92:95], v[28:31], v[140:143]
    s_branch L_wo_s7
.p2align 12, , 450
L_wm_s7:
    s_setpc_b64 s[18:19]
L_wo_s7:
    v_cndmask_b32 v128, v128, v132, s[44:45]
    v_cndmask_b32 v129, v129, v133, s[44:45]
    v_cndmask_b32 v130, v130, v134, s[44:45]
    v_cndmask_b32 v131, v131, v135, s[44:45]
    v_cndmask_b32 v128, v128, v136, s[46:47]
    v_cndmask_b32 v129, v129, v137, s[46:47]
    v_cndmask_b32 v130, v130, v138, s[46:47]
    v_cndmask_b32 v131, v131, v139, s[46:47]
    v_cndmask_b32 v128, v128, v140, s[48:49]
    v_cndmask_b32 v129, v129, v141, s[48:49]
    v_cndmask_b32 v130, v130, v142, s[48:49]
    v_cndmask_b32 v131, v131, v143, s[48:49]
    v_cvt_pk_bf16_f32 v40, v128, v129
    v_cvt_pk_bf16_f32 v41, v130, v131
    v_lshlrev_b32 v32, 16, v40
    v_and_b32 v33, s62, v40
    v_lshlrev_b32 v34, 16, v41
    v_and_b32 v35, s62, v41
    v_mul_f32 v32, s56, v32
    v_mul_f32 v33, s56, v33
    v_mul_f32 v34, s56, v34
    v_mul_f32 v35, s56, v35
    v_cvt_pk_bf16_f32 v40, v32, v33
    v_cvt_pk_bf16_f32 v41, v34, v35
    v_lshlrev_b32 v32, 16, v40
    v_and_b32 v33, s62, v40
    v_lshlrev_b32 v34, 16, v41
    v_and_b32 v35, s62, v41
    v_max3_f32 v40, v32, v33, v34
    v_max_f32 v40, v40, v35
    s_waitcnt lgkmcnt(0)
    v_or_b32 v8, v8, v9
    v_max_f32_dpp v40, v40, v40 row_ror:4 row_mask:0xf bank_mask:0xf
    s_nop 1
    v_max_f32_dpp v40, v40, v40 row_ror:8 row_mask:0xf bank_mask:0xf
    v_mov_b32 v41, v40
    s_nop 1
    v_permlane16_swap_b32 v40, v41
    v_max_f32 v40, v40, v41
    v_mov_b32 v41, v40
    s_nop 1
    v_permlane32_swap_b32 v40, v41
    v_max_f32 v40, v40, v41
    v_readfirstlane_b32 s60, v8
    v_sub_f32 v32, v32, v40
    v_sub_f32 v33, v33, v40
    v_sub_f32 v34, v34, v40
    v_sub_f32 v35, v35, v40
    v_mul_f32 v32, s57, v32
    v_mul_f32 v33, s57, v33
    v_mul_f32 v34, s57, v34
    v_mul_f32 v35, s57, v35
    v_exp_f32 v32, v32
    v_exp_f32 v33, v33
    v_exp_f32 v34, v34
    v_exp_f32 v35, v35
    v_mul_f32 v40, s57, v40
    v_cvt_pk_bf16_f32 v44, v32, v33
    v_cvt_pk_bf16_f32 v45, v34, v35
    ds_write_b64 v106, v[44:45]
    ds_write_b32 v107, v40
    v_add_f32 v32, v32, v33
    v_add_f32 v34, v34, v35
    v_add_f32 v32, v32, v34
    s_nop 1
    v_add_f32_dpp v32, v32, v32 row_ror:4 row_mask:0xf bank_mask:0xf
    s_nop 1
    v_add_f32_dpp v32, v32, v32 row_ror:8 row_mask:0xf bank_mask:0xf
    v_mov_b32 v33, v32
    s_nop 1
    v_permlane16_swap_b32 v32, v33
    v_add_f32 v32, v32, v33
    v_mov_b32 v33, v32
    s_nop 1
    v_permlane32_swap_b32 v32, v33
    v_add_f32 v32, v32, v33
    ds_write_b32 v107, v32 offset:16
    s_cmp_eq_u32 s60, 0
    s_cbranch_scc1 L_nowb
    s_waitcnt vmcnt(0)
    buffer_wbl2 sc1
L_nowb:
    s_branch L_wo_s8
.p2align 12, , 500
L_wm_s8:
    s_setpc_b64 s[18:19]
L_wo_s8:
    s_waitcnt lgkmcnt(0)
    s_barrier
    ds_read_b128 v[40:43], v122
    ds_read_b128 v[44:47], v122 offset:16
    ds_read_b128 v[148:151], v250 offset:0
    ds_read_b128 v[152:155], v250 offset:256
    ds_read_b128 v[156:159], v250 offset:512
    ds_read_b128 v[160:163], v250 offset:768
    ds_read_b128 v[164:167], v250 offset:1024
    ds_read_b128 v[168:171], v250 offset:1280
    ds_read_b128 v[172:175], v250 offset:1536
    ds_read_b128 v[176:179], v250 offset:1792
    s_waitcnt lgkmcnt(8)
    v_max3_f32 v48, v40, v41, v42
    v_max_f32 v48, v48, v43
    v_sub_f32 v40, v40, v48
    v_sub_f32 v41, v41, v48
    v_sub_f32 v42, v42, v48
    v_sub_f32 v43, v43, v48
    v_exp_f32 v40, v40
    v_exp_f32 v41, v41
    v_exp_f32 v42, v42
    v_exp_f32 v43, v43
    v_mul_f32 v49, v40, v44
    v_fmac_f32 v49, v41, v45
    v_fmac_f32 v49, v42, v46
    v_fmac_f32 v49, v43, v47
    v_log_f32 v50, v49
    v_rcp_f32 v49, v49
    s_cmp_lg_u32 s3, 3
    s_cbranch_scc1 L_nostat
    v_add_f32 v52, v50, v48
    s_mov_b64 exec, 15
    global_store_dword v118, v52, s[28:29]
    s_mov_b64 exec, -1
L_nostat:
    s_waitcnt lgkmcnt(0)
    ds_read_b64_tr_b16 v[180:181], v248 offset:0
    ds_read_b64_tr_b16 v[182:183], v248 offset:4096
    ds_read_b64_tr_b16 v[184:185], v249 offset:0
    ds_read_b64_tr_b16 v[186:187], v249 offset:4096
    ds_read_b64_tr_b16 v[188:189], v248 offset:8192
    ds_read_b64_tr_b16 v[190:191], v248 offset:12288
    ds_read_b64_tr_b16 v[192:193], v249 offset:8192
    ds_read_b64_tr_b16 v[194:195], v249 offset:12288
    ds_read_b64_tr_b16 v[196:197], v248 offset:16384
    ds_read_b64_tr_b16 v[198:199], v248 offset:20480
    ds_read_b64_tr_b16 v[200:201], v249 offset:16384
    ds_read_b64_tr_b16 v[202:203], v249 offset:20480
    ds_read_b64_tr_b16 v[204:205], v248 offset:24576
    ds_read_b64_tr_b16 v[206:207], v248 offset:28672
    ds_read_b64_tr_b16 v[208:209], v249 offset:24576
    ds_read_b64_tr_b16 v[210:211], v249 offset:28672
    v_mul_f32 v244, v40, v49
    v_mul_f32 v245, v41, v49
    v_mul_f32 v246, v42, v49
    v_mul_f32 v247, v43, v49
    s_waitcnt lgkmcnt(12)
    v_mfma_f32_16x16x32_bf16 v[212:215], v[180:183], v[148:151], 0
    v_mfma_f32_16x16x32_bf16 v[216:219], v[184:187], v[148:151], 0
    s_waitcnt lgkmcnt(8)
    v_mfma_f32_16x16x32_bf16 v[212:215], v[188:191], v[152:155], v[212:215]
    v_mfma_f32_16x16x32_bf16 v[216:219], v[192:195], v[152:155], v[216:219]
    s_waitcnt lgkmcnt(4)
    v_mfma_f32_16x16x32_bf16 v[220:223], v[196:199], v[156:159], 0
    v_mfma_f32_16x16x32_bf16 v[224:227], v[200:203], v[156:159], 0
    s_waitcnt lgkmcnt(0)
    v_mfma_f32_16x16x32_bf16 v[220:223], v[204:207], v[160:163], v[220:223]
    v_mfma_f32_16x16x32_bf16 v[224:227], v[208:211], v[160:163], v[224:227]
    s_nop 0
    v_mul_f32 v212, v212, v244
    v_mul_f32 v213, v213, v244
    v_mul_f32 v214, v214, v244
    v_mul_f32 v215, v215, v244
    v_mul_f32 v216, v216, v244
    v_mul_f32 v217, v217, v244
    v_mul_f32 v218, v218, v244
    v_mul_f32 v219, v219, v244
    v_fmac_f32 v212, v220, v245
    v_fmac_f32 v213, v221, v245
    v_fmac_f32 v214, v222, v245
    v_fmac_f32 v215, v223, v245
    v_fmac_f32 v216, v224, v245
    v_fmac_f32 v217, v225, v245
    v_fmac_f32 v218, v226, v245
    v_fmac_f32 v219, v227, v245
    s_branch L_wo_s9
.p2align 12, , 400
L_wm_s9:
    s_setpc_b64 s[18:19]
L_wo_s9:
    s_barrier
    ds_read_b64_tr_b16 v[180:181], v248 offset:32768
    ds_read_b64_tr_b16 v[182:183], v248 offset:36864
    ds_read_b64_tr_b16 v[184:185], v249 offset:32768
    ds_read_b64_tr_b16 v[186:187], v249 offset:36864
    ds_read_b64_tr_b16 v[188:189], v248 offset:40960
    ds_read_b64_tr_b16 v[190:191], v248 offset:45056
    ds_read_b64_tr_b16 v[192:193], v249 offset:40960
    ds_read_b64_tr_b16 v[194:195], v249 offset:45056
    s_waitcnt lgkmcnt(4)
    v_mfma_f32_16x16x32_bf16 v[228:231], v[180:183], v[164:167], 0
    v_mfma_f32_16x16x32_bf16 v[232:235], v[184:187], v[164:167], 0
    s_waitcnt lgkmcnt(0)
    v_mfma_f32_16x16x32_bf16 v[228:231], v[188:191], v[168:171], v[228:231]
    v_mfma_f32_16x16x32_bf16 v[232:235], v[192:195], v[168:171], v[232:235]
    s_nop 6
    v_fmac_f32 v212, v228, v246
    v_fmac_f32 v213, v229, v246
    v_fmac_f32 v214, v230, v246
    v_fmac_f32 v215, v231, v246
    v_fmac_f32 v216, v232, v246
    v_fmac_f32 v217, v233, v246
    v_fmac_f32 v218, v234, v246
    v_fmac_f32 v219, v235, v246
    s_cmp_eq_u32 s60, 0
    s_barrier
    ds_read_b64_tr_b16 v[196:197], v248 offset:49152
    ds_read_b64_tr_b16 v[198:199], v248 offset:53248
    ds_read_b64_tr_b16 v[200:201], v249 offset:49152
    ds_read_b64_tr_b16 v[202:203], v249 offset:53248
    ds_read_b64_tr_b16 v[204:205], v248 offset:57344
    ds_read_b64_tr_b16 v[206:207], v248 offset:61440
    ds_read_b64_tr_b16 v[208:209], v249 offset:57344
    ds_read_b64_tr_b16 v[210:211], v249 offset:61440
    s_waitcnt lgkmcnt(4)
    v_mfma_f32_16x16x32_bf16 v[236:239], v[196:199], v[172:175], 0
    v_mfma_f32_16x16x32_bf16 v[240:243], v[200:203], v[172:175], 0
    s_waitcnt lgkmcnt(0)
    v_mfma_f32_16x16x32_bf16 v[236:239], v[204:207], v[176:179], v[236:239]
    v_mfma_f32_16x16x32_bf16 v[240:243], v[208:211], v[176:179], v[240:243]
    s_mov_b64 exec, s[64:65]
    s_nop 5
    v_fmac_f32 v212, v236, v247
    v_fmac_f32 v213, v237, v247
    v_fmac_f32 v214, v238, v247
    v_fmac_f32 v215, v239, v247
    v_cvt_pk_bf16_f32 v40, v212, v213
    v_cvt_pk_bf16_f32 v41, v214, v215
    v_fmac_f32 v216, v240, v247
    v_fmac_f32 v217, v241, v247
    v_fmac_f32 v218, v242, v247
    v_fmac_f32 v219, v243, v247
    v_cvt_pk_bf16_f32 v42, v216, v217
    v_cvt_pk_bf16_f32 v43, v218, v219
    global_store_dwordx4 v251, v[40:43], s[28:29]
    s_mov_b64 exec, -1
    s_cbranch_scc1 L_sbc
    s_waitcnt vmcnt(0)
L_sbc:
    s_barrier
    s_barrier
    s_cmp_eq_u32 s3, 0
    s_cbranch_scc1 L_final
    s_endpgm
.p2align 12, , 400
L_wm_s10:
    s_setpc_b64 s[18:19]
    s_nop 0
L_final:
    s_mov_b32 s57, 0
    v_lshlrev_b32 v28, 16, v119
    v_mov_b32 v33, s35
    s_movk_i32 s56, 0xff00
    s_mov_b32 s44, 0x00010001
    s_mov_b32 s45, 0x00010001
    s_barrier
    s_mov_b64 vcc, -1
L_fpoll:
    s_mov_b64 exec, vcc
    global_load_dwordx4 v[20:23], v116, s[28:29] sc1
    s_mov_b64 exec, -1
    s_add_u32 s57, s57, 1
    s_cmp_lt_u32 s57, 40000
    s_cselect_b64 s[46:47], -1, 0
    s_waitcnt vmcnt(0)
    v_and_b32 v16, s56, v20
    v_and_b32 v17, s56, v21
    v_perm_b32 v24, v21, v20, s58
    v_perm_b32 v25, v23, v22, s59
    v_and_b32 v18, s56, v22
    v_and_b32 v19, s56, v23
    v_permlane32_swap_b32 v16, v17
    v_or_b32 v24, v24, v25
    v_cmp_ne_u32 vcc, s35, v24
    v_permlane32_swap_b32 v18, v19
    v_add_f32 v16, v16, v17
    v_add_f32 v18, v18, v19
    s_and_b64 vcc, vcc, s[46:47]
    s_cbranch_scc1 L_fpoll
    v_permlane16_swap_b32 v16, v18
    v_add_f32 v16, v16, v18
    s_nop 1
    v_add_f32_dpp v16, v16, v16 quad_perm:[1,0,3,2] row_mask:0xf bank_mask:0xf
    s_nop 1
    v_add_f32_dpp v16, v16, v16 quad_perm:[2,3,0,1] row_mask:0xf bank_mask:0xf
    s_nop 1
    v_add_f32_dpp v16, v16, v16 row_ror:4 row_mask:0xf bank_mask:0xf
    s_nop 1
    v_add_f32_dpp v16, v16, v16 row_ror:8 row_mask:0xf bank_mask:0xf
    v_add_f32 v16, v16, v28
    v_cvt_pk_bf16_f32 v16, v16, v16
    s_mov_b64 exec, s[44:45]
    global_store_short v120, v16, s[26:27]
    s_cmp_lg_u32 s2, 0
    s_cbranch_scc1 L_end
    s_mov_b64 exec, 1
    v_mov_b32 v19, 0
    global_store_dword v19, v33, s[30:31]
L_end:
    s_endpgm
.p2align 6
.p2align 12, , 1400
L_wm_t0:
    s_setpc_b64 s[18:19]
    s_nop 0
L_ltail:
    s_waitcnt vmcnt(9)
    s_barrier
    ds_read_b64_tr_b16 v[80:81], v111 offset:4096
    ds_read_b64_tr_b16 v[82:83], v111 offset:5120
    ds_read_b64_tr_b16 v[84:85], v112 offset:4096
    ds_read_b64_tr_b16 v[86:87], v112 offset:5120
    ds_read_b64_tr_b16 v[88:89], v113 offset:4096
    ds_read_b64_tr_b16 v[90:91], v113 offset:5120
    ds_read_b64_tr_b16 v[92:93], v114 offset:4096
    ds_read_b64_tr_b16 v[94:95], v114 offset:5120
    s_mov_b32 s63, 0
L_gcheck:
    v_perm_b32 v48, v125, v124, s36
    v_perm_b32 v49, v127, v126, s37
    v_perm_b32 v50, v29, v28, s36
    v_perm_b32 v51, v31, v30, s37
    v_or_b32 v48, v48, v49
    v_or_b32 v50, v50, v51
    v_xor_b32 v48, s35, v48
    v_xor_b32 v50, s35, v50
    v_or_b32 v48, v48, v50
    v_and_b32 v48, s38, v48
    v_cmp_ne_u32 vcc, 0, v48
    s_movk_i32 s58, 0xff00
    s_cbranch_vccnz L_gpoll
L_gdone:
    v_and_b32 v124, s58, v124
    v_and_b32 v125, s58, v125
    v_and_b32 v126, s58, v126
    v_and_b32 v127, s58, v127
    v_and_b32 v28, s58, v28
    v_and_b32 v29, s58, v29
    v_and_b32 v30, s58, v30
    v_and_b32 v31, s58, v31
    v_pk_add_f32 v[124:125], v[124:125], v[28:29]
    v_pk_add_f32 v[126:127], v[126:127], v[30:31]
    v_cmp_eq_u32 s[44:45], 0, v1
    v_cmp_eq_u32 s[46:47], 1, v1
    v_add_f32_dpp v124, v124, v124 row_ror:4 row_mask:0xf bank_mask:0xf
    v_add_f32_dpp v125, v125, v125 row_ror:4 row_mask:0xf bank_mask:0xf
    v_add_f32_dpp v126, v126, v126 row_ror:4 row_mask:0xf bank_mask:0xf
    v_add_f32_dpp v127, v127, v127 row_ror:4 row_mask:0xf bank_mask:0xf
    v_add_f32_dpp v124, v124, v124 row_ror:8 row_mask:0xf bank_mask:0xf
    v_add_f32_dpp v125, v125, v125 row_ror:8 row_mask:0xf bank_mask:0xf
    v_add_f32_dpp v126, v126, v126 row_ror:8 row_mask:0xf bank_mask:0xf
    v_add_f32_dpp v127, v127, v127 row_ror:8 row_mask:0xf bank_mask:0xf
    v_cvt_pk_bf16_f32 v48, v124, v125
    v_cvt_pk_bf16_f32 v49, v126, v127
    v_lshlrev_b32 v124, 16, v48
    v_and_b32 v125, s62, v48
    v_lshlrev_b32 v126, 16, v49
    v_and_b32 v127, s62, v49
    v_max_f32 v48, 0, v124
    v_max_f32 v49, 0, v125
    v_max_f32 v50, 0, v126
    v_max_f32 v51, 0, v127
    v_mul_f32_dpp v48, v124, v48 quad_perm:[2,3,0,1] row_mask:0xf bank_mask:0xf
    v_mul_f32_dpp v49, v125, v49 quad_perm:[2,3,0,1] row_mask:0xf bank_mask:0xf
    v_mul_f32_dpp v50, v126, v50 quad_perm:[2,3,0,1] row_mask:0xf bank_mask:0xf
    v_mul_f32_dpp v51, v127, v51 quad_perm:[2,3,0,1] row_mask:0xf bank_mask:0xf
    v_cvt_pk_bf16_f32 v48, v48, v49
    v_cvt_pk_bf16_f32 v49, v50, v51
    v_cndmask_b32 v28, 0, v48, s[44:45]
    v_cndmask_b32 v29, 0, v49, s[44:45]
    v_cndmask_b32 v30, 0, v48, s[46:47]
    v_cndmask_b32 v31, 0, v49, s[46:47]
    s_waitcnt lgkmcnt(0)
    s_nop 0
    v_mfma_f32_16x16x32_bf16 v[128:131], v[28:31], v[80:83], 0
    v_mfma_f32_16x16x32_bf16 v[132:135], v[28:31], v[84:87], 0
    v_mfma_f32_16x16x32_bf16 v[136:139], v[28:31], v[88:91], 0
    v_mfma_f32_16x16x32_bf16 v[140:143], v[28:31], v[92:95], 0
    s_mov_b32 s44, 0x11111111
    s_mov_b32 s45, 0x11111111
    s_nop 2
    v_add_f32 v128, v128, v129
    v_add_f32 v132, v132, v133
    v_add_f32 v136, v136, v137
    v_add_f32 v140, v140, v141
    v_permlane32_swap_b32 v128, v132
    s_nop 0
    v_permlane32_swap_b32 v136, v140
    v_add_f32 v128, v128, v132
    v_add_f32 v136, v136, v140
    s_mov_b32 s63, 0
    s_nop 0
    v_permlane16_swap_b32 v128, v136
    v_add_f32 v36, v128, v136
    s_branch L_wo_t1
.p2align 12, , 400
L_wm_t1:
    s_setpc_b64 s[18:19]
L_wo_t1:
    s_waitcnt vmcnt(5)
    s_barrier
    s_waitcnt vmcnt(4)
    v_cmp_eq_u32 vcc, -1, v24
    v_max_f32_dpp v124, v24, v24 quad_perm:[1,0,3,2] row_mask:0xf bank_mask:0xf
    s_nop 1
    v_max_f32_dpp v124, v124, v124 quad_perm:[2,3,0,1] row_mask:0xf bank_mask:0xf
    v_mov_b32 v125, v124
    s_nop 1
    v_permlane16_swap_b32 v124, v125
    v_max_f32 v124, v124, v125
    v_mov_b32 v125, v124
    s_nop 1
    v_permlane32_swap_b32 v124, v125
    v_max_f32 v124, v124, v125
    v_sub_f32 v8, v24, v124
    v_exp_f32 v8, v8
    s_nop 1
    v_add_f32_dpp v9, v8, v8 quad_perm:[1,0,3,2] row_mask:0xf bank_mask:0xf
    s_nop 1
    v_add_f32_dpp v9, v9, v9 quad_perm:[2,3,0,1] row_mask:0xf bank_mask:0xf
    v_mov_b32 v125, v9
    s_nop 1
    v_permlane16_swap_b32 v9, v125
    v_add_f32 v9, v9, v125
    v_mov_b32 v125, v9
    s_nop 1
    v_permlane32_swap_b32 v9, v125
    v_add_f32 v9, v9, v125
    v_rcp_f32 v9, v9
    s_nop 0
    v_mul_f32 v8, v8, v9
    s_nop 1
    v_mov_b32_dpp v10, v8 quad_perm:[0,0,0,0] row_mask:0xf bank_mask:0xf
    v_mov_b32_dpp v11, v8 quad_perm:[1,1,1,1] row_mask:0xf bank_mask:0xf
    v_mov_b32_dpp v12, v8 quad_perm:[2,2,2,2] row_mask:0xf bank_mask:0xf
    v_mov_b32_dpp v13, v8 quad_perm:[3,3,3,3] row_mask:0xf bank_mask:0xf
    s_cmp_eq_u32 s69, 0
    s_barrier
    s_cbranch_scc0 L_slow
L_fast2:
    s_cbranch_vccz L_nosg
    global_load_dword v24, v110, s[28:29] sc1
L_nosg:
    global_load_dwordx4 v[16:19], v109, s[28:29] sc1
    global_load_dwordx4 v[20:23], v109, s[28:29] offset:2048 sc1
    s_branch L_wo_t2
.p2align 12, , 400
L_wm_t2:
    s_setpc_b64 s[18:19]
L_wo_t2:
    s_waitcnt vmcnt(2)
    s_barrier
    ds_read_b64_tr_b16 v[48:49], v111 offset:0
    ds_read_b64_tr_b16 v[50:51], v111 offset:1024
    ds_read_b64_tr_b16 v[52:53], v112 offset:0
    ds_read_b64_tr_b16 v[54:55], v112 offset:1024
    ds_read_b64_tr_b16 v[56:57], v113 offset:0
    ds_read_b64_tr_b16 v[58:59], v113 offset:1024
    ds_read_b64_tr_b16 v[60:61], v114 offset:0
    ds_read_b64_tr_b16 v[62:63], v114 offset:1024
    ds_read_b64_tr_b16 v[64:65], v111 offset:2048
    ds_read_b64_tr_b16 v[66:67], v111 offset:3072
    ds_read_b64_tr_b16 v[68:69], v112 offset:2048
    ds_read_b64_tr_b16 v[70:71], v112 offset:3072
    ds_read_b64_tr_b16 v[72:73], v113 offset:2048
    ds_read_b64_tr_b16 v[74:75], v113 offset:3072
    ds_read_b64_tr_b16 v[76:77], v114 offset:2048
    ds_read_b64_tr_b16 v[78:79], v114 offset:3072
    s_cbranch_vccnz L_spoll1
L_ochk:
    s_waitcnt vmcnt(0) lgkmcnt(0)
    v_mfma_f32_16x16x32_bf16 v[128:131], v[16:19], v[48:51], 0
    v_max3_u32 v124, v16, v17, v18
    v_max3_u32 v125, v19, v20, v21
    v_mfma_f32_16x16x32_bf16 v[128:131], v[20:23], v[64:67], v[128:131]
    v_max3_u32 v124, v124, v22, v23
    v_max_u32 v124, v124, v125
    v_mfma_f32_16x16x32_bf16 v[132:135], v[16:19], v[52:55], 0
    v_cmp_eq_u32 vcc, -1, v124
    s_cbranch_vccnz L_opoll
L_odone:
    v_mfma_f32_16x16x32_bf16 v[132:135], v[20:23], v[68:71], v[132:135]
    v_mfma_f32_16x16x32_bf16 v[136:139], v[16:19], v[56:59], 0
    v_mfma_f32_16x16x32_bf16 v[136:139], v[20:23], v[72:75], v[136:139]
    v_mul_f32 v128, v10, v128
    v_fmac_f32 v128, v11, v129
    v_mfma_f32_16x16x32_bf16 v[140:143], v[16:19], v[60:63], 0
    v_fmac_f32 v128, v12, v130
    v_fmac_f32 v128, v13, v131
    v_mfma_f32_16x16x32_bf16 v[140:143], v[20:23], v[76:79], v[140:143]
    v_mul_f32 v132, v10, v132
    v_fmac_f32 v132, v11, v133
    v_fmac_f32 v132, v12, v134
    v_fmac_f32 v132, v13, v135
    v_mul_f32 v136, v10, v136
    v_fmac_f32 v136, v11, v137
    v_fmac_f32 v136, v12, v138
    v_fmac_f32 v136, v13, v139
    v_permlane32_swap_b32 v128, v132
    v_add_f32 v128, v128, v132
    v_mul_f32 v140, v10, v140
    v_fmac_f32 v140, v11, v141
    v_fmac_f32 v140, v12, v142
    v_fmac_f32 v140, v13, v143
    s_nop 1
    v_permlane32_swap_b32 v136, v140
    v_add_f32 v136, v136, v140
    s_nop 1
    v_permlane16_swap_b32 v128, v136
    v_add_f32 v36, v36, v128
    v_add_f32 v36, v36, v136
    v_bfi_b32 v36, v121, v117, v36
    s_nop 1
    v_mov_b32_dpp v37, v36 quad_perm:[1,1,1,1] row_mask:0xf bank_mask:0xf
    v_mov_b32_dpp v38, v36 quad_perm:[2,2,2,2] row_mask:0xf bank_mask:0xf
    v_mov_b32_dpp v39, v36 quad_perm:[3,3,3,3] row_mask:0xf bank_mask:0xf
    s_mov_b64 exec, s[44:45]
    global_store_dwordx4 v115, v[36:39], s[30:31] sc1
    s_waitcnt vmcnt(0)
    s_barrier
    s_endpgm
.p2align 12, , 400
L_wm_t4:
    s_setpc_b64 s[18:19]
    s_nop 0
L_opoll:
    s_mov_b64 exec, vcc
    global_load_dwordx4 v[16:19], v109, s[28:29] sc1
    global_load_dwordx4 v[20:23], v109, s[28:29] offset:2048 sc1
    s_mov_b64 exec, -1
    s_add_u32 s63, s63, 1
    s_cmp_lt_u32 s63, 40000
    s_cbranch_scc1 L_ochk
    s_waitcnt vmcnt(0)
    s_branch L_odone
L_spoll:
    s_waitcnt vmcnt(0)
    global_load_dword v24, v110, s[28:29] sc1
    global_load_dwordx4 v[16:19], v109, s[28:29] sc1
    global_load_dwordx4 v[20:23], v109, s[28:29] offset:2048 sc1
L_spoll1:
    s_waitcnt vmcnt(2)
    v_cmp_eq_u32 vcc, -1, v24
    s_add_u32 s63, s63, 1
    s_cbranch_vccz L_sdone
    s_cmp_lt_u32 s63, 40000
    s_nop 0
    s_cbranch_scc1 L_spoll
L_sdone:
    v_max_f32_dpp v124, v24, v24 quad_perm:[1,0,3,2] row_mask:0xf bank_mask:0xf
    s_nop 1
    v_max_f32_dpp v124, v124, v124 quad_perm:[2,3,0,1] row_mask:0xf bank_mask:0xf
    v_mov_b32 v125, v124
    s_nop 1
    v_permlane16_swap_b32 v124, v125
    v_max_f32 v124, v124, v125
    v_mov_b32 v125, v124
    s_nop 1
    v_permlane32_swap_b32 v124, v125
    v_max_f32 v124, v124, v125
    v_sub_f32 v8, v24, v124
    v_exp_f32 v8, v8
    s_nop 1
    v_add_f32_dpp v9, v8, v8 quad_perm:[1,0,3,2] row_mask:0xf bank_mask:0xf
    s_nop 1
    v_add_f32_dpp v9, v9, v9 quad_perm:[2,3,0,1] row_mask:0xf bank_mask:0xf
    v_mov_b32 v125, v9
    s_nop 1
    v_permlane16_swap_b32 v9, v125
    v_add_f32 v9, v9, v125
    v_mov_b32 v125, v9
    s_nop 1
    v_permlane32_swap_b32 v9, v125
    v_add_f32 v9, v9, v125
    v_rcp_f32 v9, v9
    s_nop 0
    v_mul_f32 v8, v8, v9
    s_nop 1
    v_mov_b32_dpp v10, v8 quad_perm:[0,0,0,0] row_mask:0xf bank_mask:0xf
    v_mov_b32_dpp v11, v8 quad_perm:[1,1,1,1] row_mask:0xf bank_mask:0xf
    v_mov_b32_dpp v12, v8 quad_perm:[2,2,2,2] row_mask:0xf bank_mask:0xf
    v_mov_b32_dpp v13, v8 quad_perm:[3,3,3,3] row_mask:0xf bank_mask:0xf
    s_nop 0
    s_branch L_ochk
L_gpoll:
    s_add_u32 s63, s63, 1
    s_cmp_ge_u32 s63, 40000
    s_cbranch_scc1 L_gdone
    s_cmp_eq_u32 s69, 0
    s_cbranch_scc1 L_gload
    buffer_inv sc1
    s_waitcnt vmcnt(0)
L_gload:
    global_load_dwordx4 v[124:127], v108, s[28:29] offset:-2048 sc1 nt
    global_load_dwordx4 v[28:31], v108, s[28:29] offset:2048 sc1 nt
    s_waitcnt vmcnt(0)
    s_branch L_gcheck
L_slow:
    s_cmp_lg_u32 s3, 4
    s_cbranch_scc1 L_slow2
    buffer_wbl2 sc1
    s_waitcnt vmcnt(0)
    s_mov_b64 exec, 1
    global_store_dword v118, v33, s[28:29] sc1
    s_mov_b64 exec, -1
L_slow2:
    global_load_dword v34, v123, s[28:29] sc1
    s_waitcnt vmcnt(0)
    v_cmp_ne_u32 vcc, s35, v34
    s_add_u32 s63, s63, 1
    s_cbranch_vccz L_slow3
    s_cmp_lt_u32 s63, 40000
    s_nop 0
    s_cbranch_scc1 L_slow2
L_slow3:
    buffer_inv sc1
    s_waitcnt vmcnt(0)
    s_mov_b32 s63, 0
    s_mov_b64 vcc, -1
    s_branch L_fast2
L_code_end:
    s_endpgm
.section .rodata,"a"
.p2align 6
.amdhsa_kernel parallel_sum__sliding_block_cached__glu_gated_reglu__decode_kernel
  .amdhsa_next_free_vgpr 256
  .amdhsa_next_free_sgpr 102
  .amdhsa_accum_offset 256
  .amdhsa_group_segment_fixed_size 0
  .amdhsa_kernarg_size 96
  .amdhsa_user_sgpr_count 2
  .amdhsa_user_sgpr_kernarg_segment_ptr 1
  .amdhsa_system_sgpr_workgroup_id_x 1
  .amdhsa_float_denorm_mode_32 3
.end_amdhsa_kernel
```
